```python
import torch

def _softmax(x, axis=-1):
    return torch.softmax(x, dim=axis)
def _gelu(x):
    return torch.nn.functional.gelu(x, approximate="tanh")
def _silu(x):
    return torch.nn.functional.silu(x)
def _sigmoid(x):
    return torch.sigmoid(x)
def _layernorm(x, axis=-1, eps=1e-5):
    m = x.mean(dim=axis, keepdim=True)
    v = x.var(dim=axis, keepdim=True, unbiased=False)
    return (x - m) / torch.sqrt(v + eps)
def _scatter_add(tgt, idx, src, axis=0):
    return tgt.clone().index_add_(axis, idx, src)
def _segment_sum(src, seg, n):
    out = torch.zeros((n,) + src.shape[1:], dtype=src.dtype)
    return out.index_add_(0, seg, src)
def _pad(x, pw):
    flat = tuple(v for pair in reversed(pw) for v in pair)
    return torch.nn.functional.pad(x, flat)

kernel_name = 'standalone__rezero__sampling'

def setup_inputs():

    _w = (lambda a: (lambda t: t.to(torch.bfloat16) if t.is_floating_point() else t)(torch.as_tensor(a)))
    B, S, D = 1024, 8, 640
    return {
        "x": _w((lambda *s: torch.randn(*s, dtype=torch.bfloat16) * 0.05)(B, S, D)),
        "fx": _w((lambda *s: torch.randn(*s, dtype=torch.bfloat16) * 0.8)(B, S, D)),
        "alpha": _w((lambda *s: torch.randn(*s, dtype=torch.bfloat16) * 0.8)(1) * 0.1),
    }

def reference(x, fx, alpha):
    return x + alpha * fx
```

```asm
; @launch grid=(512,1,1) block=(256,1,1) lds=0
.amdgcn_target "amdgcn-amd-amdhsa--gfx950"
.text
.globl standalone__rezero__sampling_kernel
.p2align 8
.type standalone__rezero__sampling_kernel,@function
standalone__rezero__sampling_kernel:
    s_load_dwordx8 s[4:11], s[0:1], 0
    s_cmpk_ge_u32 s2, 512
    s_cbranch_scc1 L_end
    s_mulk_i32 s2, 1280
    s_addk_i32 s2, 256
    v_add_lshl_u32 v0, v0, s2, 4
    v_add_u32 v1, 8192, v0
    v_add_u32 v2, 16384, v0
    s_waitcnt lgkmcnt(0)
    global_load_dwordx4 v[12:15], v0, s[6:7] offset:-4096 nt
    global_load_dwordx4 v[16:19], v0, s[4:5] offset:-4096 nt
    global_load_dwordx4 v[24:27], v0, s[6:7] nt
    global_load_dwordx4 v[28:31], v0, s[4:5] nt
    global_load_dwordx4 v[36:39], v1, s[6:7] offset:-4096 nt
    global_load_dwordx4 v[40:43], v1, s[4:5] offset:-4096 nt
    global_load_dwordx4 v[48:51], v1, s[6:7] nt
    global_load_dwordx4 v[52:55], v1, s[4:5] nt
    global_load_dwordx4 v[60:63], v2, s[6:7] offset:-4096 nt
    global_load_dwordx4 v[64:67], v2, s[4:5] offset:-4096 nt
    s_load_dword s12, s[8:9], 0
    s_mov_b32 s14, 0xffff0000
    s_waitcnt lgkmcnt(0)
    s_lshl_b32 s12, s12, 16
    s_mov_b32 s13, s12
    s_waitcnt vmcnt(9)
    v_lshlrev_b32 v8, 16, v12
    v_and_b32 v9, s14, v12
    v_lshlrev_b32 v10, 16, v13
    v_and_b32 v11, s14, v13
    v_lshlrev_b32 v12, 16, v14
    v_and_b32 v13, s14, v14
    v_lshlrev_b32 v14, 16, v15
    v_and_b32 v15, s14, v15
    v_pk_mul_f32 v[8:9], v[8:9], s[12:13]
    v_pk_mul_f32 v[10:11], v[10:11], s[12:13]
    v_pk_mul_f32 v[12:13], v[12:13], s[12:13]
    v_pk_mul_f32 v[14:15], v[14:15], s[12:13]
    v_cvt_pk_bf16_f32 v8, 0, v8
    v_cvt_pk_bf16_f32 v9, 0, v9
    v_cvt_pk_bf16_f32 v10, 0, v10
    v_cvt_pk_bf16_f32 v11, 0, v11
    v_cvt_pk_bf16_f32 v12, 0, v12
    v_cvt_pk_bf16_f32 v13, 0, v13
    v_cvt_pk_bf16_f32 v14, 0, v14
    v_cvt_pk_bf16_f32 v15, 0, v15
    s_waitcnt vmcnt(8)
    v_lshlrev_b32 v68, 16, v16
    v_and_b32 v69, s14, v16
    v_pk_add_f32 v[68:69], v[68:69], v[8:9]
    v_cvt_pk_bf16_f32 v16, v68, v69
    v_lshlrev_b32 v70, 16, v17
    v_and_b32 v71, s14, v17
    v_pk_add_f32 v[70:71], v[70:71], v[10:11]
    v_cvt_pk_bf16_f32 v17, v70, v71
    v_lshlrev_b32 v68, 16, v18
    v_and_b32 v69, s14, v18
    v_pk_add_f32 v[68:69], v[68:69], v[12:13]
    v_cvt_pk_bf16_f32 v18, v68, v69
    v_lshlrev_b32 v70, 16, v19
    v_and_b32 v71, s14, v19
    v_pk_add_f32 v[70:71], v[70:71], v[14:15]
    v_cvt_pk_bf16_f32 v19, v70, v71
    global_store_dwordx4 v0, v[16:19], s[10:11] offset:-4096
    s_waitcnt vmcnt(8)
    v_lshlrev_b32 v20, 16, v24
    v_and_b32 v21, s14, v24
    v_lshlrev_b32 v22, 16, v25
    v_and_b32 v23, s14, v25
    v_lshlrev_b32 v24, 16, v26
    v_and_b32 v25, s14, v26
    v_lshlrev_b32 v26, 16, v27
    v_and_b32 v27, s14, v27
    v_pk_mul_f32 v[20:21], v[20:21], s[12:13]
    v_pk_mul_f32 v[22:23], v[22:23], s[12:13]
    v_pk_mul_f32 v[24:25], v[24:25], s[12:13]
    v_pk_mul_f32 v[26:27], v[26:27], s[12:13]
    v_cvt_pk_bf16_f32 v20, 0, v20
    v_cvt_pk_bf16_f32 v21, 0, v21
    v_cvt_pk_bf16_f32 v22, 0, v22
    v_cvt_pk_bf16_f32 v23, 0, v23
    v_cvt_pk_bf16_f32 v24, 0, v24
    v_cvt_pk_bf16_f32 v25, 0, v25
    v_cvt_pk_bf16_f32 v26, 0, v26
    v_cvt_pk_bf16_f32 v27, 0, v27
    s_waitcnt vmcnt(7)
    v_lshlrev_b32 v68, 16, v28
    v_and_b32 v69, s14, v28
    v_pk_add_f32 v[68:69], v[68:69], v[20:21]
    v_cvt_pk_bf16_f32 v28, v68, v69
    v_lshlrev_b32 v70, 16, v29
    v_and_b32 v71, s14, v29
    v_pk_add_f32 v[70:71], v[70:71], v[22:23]
    v_cvt_pk_bf16_f32 v29, v70, v71
    v_lshlrev_b32 v68, 16, v30
    v_and_b32 v69, s14, v30
    v_pk_add_f32 v[68:69], v[68:69], v[24:25]
    v_cvt_pk_bf16_f32 v30, v68, v69
    v_lshlrev_b32 v70, 16, v31
    v_and_b32 v71, s14, v31
    v_pk_add_f32 v[70:71], v[70:71], v[26:27]
    v_cvt_pk_bf16_f32 v31, v70, v71
    global_store_dwordx4 v0, v[28:31], s[10:11]
    s_waitcnt vmcnt(7)
    v_lshlrev_b32 v32, 16, v36
    v_and_b32 v33, s14, v36
    v_lshlrev_b32 v34, 16, v37
    v_and_b32 v35, s14, v37
    v_lshlrev_b32 v36, 16, v38
    v_and_b32 v37, s14, v38
    v_lshlrev_b32 v38, 16, v39
    v_and_b32 v39, s14, v39
    v_pk_mul_f32 v[32:33], v[32:33], s[12:13]
    v_pk_mul_f32 v[34:35], v[34:35], s[12:13]
    v_pk_mul_f32 v[36:37], v[36:37], s[12:13]
    v_pk_mul_f32 v[38:39], v[38:39], s[12:13]
    v_cvt_pk_bf16_f32 v32, 0, v32
    v_cvt_pk_bf16_f32 v33, 0, v33
    v_cvt_pk_bf16_f32 v34, 0, v34
    v_cvt_pk_bf16_f32 v35, 0, v35
    v_cvt_pk_bf16_f32 v36, 0, v36
    v_cvt_pk_bf16_f32 v37, 0, v37
    v_cvt_pk_bf16_f32 v38, 0, v38
    v_cvt_pk_bf16_f32 v39, 0, v39
    s_waitcnt vmcnt(6)
    v_lshlrev_b32 v68, 16, v40
    v_and_b32 v69, s14, v40
    v_pk_add_f32 v[68:69], v[68:69], v[32:33]
    v_cvt_pk_bf16_f32 v40, v68, v69
    v_lshlrev_b32 v70, 16, v41
    v_and_b32 v71, s14, v41
    v_pk_add_f32 v[70:71], v[70:71], v[34:35]
    v_cvt_pk_bf16_f32 v41, v70, v71
    v_lshlrev_b32 v68, 16, v42
    v_and_b32 v69, s14, v42
    v_pk_add_f32 v[68:69], v[68:69], v[36:37]
    v_cvt_pk_bf16_f32 v42, v68, v69
    v_lshlrev_b32 v70, 16, v43
    v_and_b32 v71, s14, v43
    v_pk_add_f32 v[70:71], v[70:71], v[38:39]
    v_cvt_pk_bf16_f32 v43, v70, v71
    global_store_dwordx4 v1, v[40:43], s[10:11] offset:-4096
    s_waitcnt vmcnt(6)
    v_lshlrev_b32 v44, 16, v48
    v_and_b32 v45, s14, v48
    v_lshlrev_b32 v46, 16, v49
    v_and_b32 v47, s14, v49
    v_lshlrev_b32 v48, 16, v50
    v_and_b32 v49, s14, v50
    v_lshlrev_b32 v50, 16, v51
    v_and_b32 v51, s14, v51
    v_pk_mul_f32 v[44:45], v[44:45], s[12:13]
    v_pk_mul_f32 v[46:47], v[46:47], s[12:13]
    v_pk_mul_f32 v[48:49], v[48:49], s[12:13]
    v_pk_mul_f32 v[50:51], v[50:51], s[12:13]
    v_cvt_pk_bf16_f32 v44, 0, v44
    v_cvt_pk_bf16_f32 v45, 0, v45
    v_cvt_pk_bf16_f32 v46, 0, v46
    v_cvt_pk_bf16_f32 v47, 0, v47
    v_cvt_pk_bf16_f32 v48, 0, v48
    v_cvt_pk_bf16_f32 v49, 0, v49
    v_cvt_pk_bf16_f32 v50, 0, v50
    v_cvt_pk_bf16_f32 v51, 0, v51
    s_waitcnt vmcnt(5)
    v_lshlrev_b32 v68, 16, v52
    v_and_b32 v69, s14, v52
    v_pk_add_f32 v[68:69], v[68:69], v[44:45]
    v_cvt_pk_bf16_f32 v52, v68, v69
    v_lshlrev_b32 v70, 16, v53
    v_and_b32 v71, s14, v53
    v_pk_add_f32 v[70:71], v[70:71], v[46:47]
    v_cvt_pk_bf16_f32 v53, v70, v71
    v_lshlrev_b32 v68, 16, v54
    v_and_b32 v69, s14, v54
    v_pk_add_f32 v[68:69], v[68:69], v[48:49]
    v_cvt_pk_bf16_f32 v54, v68, v69
    v_lshlrev_b32 v70, 16, v55
    v_and_b32 v71, s14, v55
    v_pk_add_f32 v[70:71], v[70:71], v[50:51]
    v_cvt_pk_bf16_f32 v55, v70, v71
    global_store_dwordx4 v1, v[52:55], s[10:11]
    s_waitcnt vmcnt(5)
    v_lshlrev_b32 v56, 16, v60
    v_and_b32 v57, s14, v60
    v_lshlrev_b32 v58, 16, v61
    v_and_b32 v59, s14, v61
    v_lshlrev_b32 v60, 16, v62
    v_and_b32 v61, s14, v62
    v_lshlrev_b32 v62, 16, v63
    v_and_b32 v63, s14, v63
    v_pk_mul_f32 v[56:57], v[56:57], s[12:13]
    v_pk_mul_f32 v[58:59], v[58:59], s[12:13]
    v_pk_mul_f32 v[60:61], v[60:61], s[12:13]
    v_pk_mul_f32 v[62:63], v[62:63], s[12:13]
    v_cvt_pk_bf16_f32 v56, 0, v56
    v_cvt_pk_bf16_f32 v57, 0, v57
    v_cvt_pk_bf16_f32 v58, 0, v58
    v_cvt_pk_bf16_f32 v59, 0, v59
    v_cvt_pk_bf16_f32 v60, 0, v60
    v_cvt_pk_bf16_f32 v61, 0, v61
    v_cvt_pk_bf16_f32 v62, 0, v62
    v_cvt_pk_bf16_f32 v63, 0, v63
    s_waitcnt vmcnt(4)
    v_lshlrev_b32 v68, 16, v64
    v_and_b32 v69, s14, v64
    v_pk_add_f32 v[68:69], v[68:69], v[56:57]
    v_cvt_pk_bf16_f32 v64, v68, v69
    v_lshlrev_b32 v70, 16, v65
    v_and_b32 v71, s14, v65
    v_pk_add_f32 v[70:71], v[70:71], v[58:59]
    v_cvt_pk_bf16_f32 v65, v70, v71
    v_lshlrev_b32 v68, 16, v66
    v_and_b32 v69, s14, v66
    v_pk_add_f32 v[68:69], v[68:69], v[60:61]
    v_cvt_pk_bf16_f32 v66, v68, v69
    v_lshlrev_b32 v70, 16, v67
    v_and_b32 v71, s14, v67
    v_pk_add_f32 v[70:71], v[70:71], v[62:63]
    v_cvt_pk_bf16_f32 v67, v70, v71
    global_store_dwordx4 v2, v[64:67], s[10:11] offset:-4096
L_end:
    s_endpgm
.section .rodata,"a"
.p2align 6
.amdhsa_kernel standalone__rezero__sampling_kernel
  .amdhsa_next_free_vgpr 72
  .amdhsa_next_free_sgpr 16
  .amdhsa_accum_offset 72
  .amdhsa_group_segment_fixed_size 0
  .amdhsa_kernarg_size 48
  .amdhsa_user_sgpr_count 2
  .amdhsa_user_sgpr_kernarg_segment_ptr 1
  .amdhsa_system_sgpr_workgroup_id_x 1
  .amdhsa_float_denorm_mode_32 3
.end_amdhsa_kernel
```
